```python
import torch

def _softmax(x, axis=-1):
    return torch.softmax(x, dim=axis)
def _gelu(x):
    return torch.nn.functional.gelu(x, approximate="tanh")
def _silu(x):
    return torch.nn.functional.silu(x)
def _sigmoid(x):
    return torch.sigmoid(x)
def _layernorm(x, axis=-1, eps=1e-5):
    m = x.mean(dim=axis, keepdim=True)
    v = x.var(dim=axis, keepdim=True, unbiased=False)
    return (x - m) / torch.sqrt(v + eps)
def _scatter_add(tgt, idx, src, axis=0):
    return tgt.clone().index_add_(axis, idx, src)
def _segment_sum(src, seg, n):
    out = torch.zeros((n,) + src.shape[1:], dtype=src.dtype)
    return out.index_add_(0, seg, src)
def _pad(x, pw):
    flat = tuple(v for pair in reversed(pw) for v in pair)
    return torch.nn.functional.pad(x, flat)

kernel_name = 'standalone__rezero__sampling'

def setup_inputs():

    _w = (lambda a: (lambda t: t.to(torch.bfloat16) if t.is_floating_point() else t)(torch.as_tensor(a)))
    B, S, D = 1024, 32, 576
    return {
        "x": _w((lambda *s: torch.randn(*s, dtype=torch.bfloat16) * 0.05)(B, S, D)),
        "fx": _w((lambda *s: torch.randn(*s, dtype=torch.bfloat16) * 0.8)(B, S, D)),
        "alpha": _w((lambda *s: torch.randn(*s, dtype=torch.bfloat16) * 0.8)(1) * 0.1),
    }

def reference(x, fx, alpha):
    return x + alpha * fx
```

```asm
; @launch grid=(256,1,1) block=(320,1,1) lds=2112
.amdgcn_target "amdgcn-amd-amdhsa--gfx950"
.text
.globl standalone__rezero__sampling_kernel
.p2align 12
.fill 832, 4, 0xbf810000
.p2align 8
.type standalone__rezero__sampling_kernel,@function
standalone__rezero__sampling_kernel:
    s_cmp_ge_u32 s2, 256
    s_cbranch_scc1 L_end
    s_load_dwordx2 s[12:13], s[0:1], 0
    s_load_dwordx2 s[16:17], s[0:1], 8
    s_load_dwordx2 s[8:9], s[0:1], 16
    s_load_dwordx2 s[24:25], s[0:1], 24
    s_load_dwordx2 s[28:29], s[0:1], 32
    s_load_dwordx2 s[4:5], s[0:1], 40
    v_readfirstlane_b32 s34, v0
    s_lshr_b32 s44, s2, 3
    s_and_b32 s30, s2, 0x20
    s_lshl_b32 s30, s30, 7
    s_and_b32 s45, s2, 0xd8
    s_lshl_b32 s45, s45, 12
    s_xor_b32 s30, s30, s45
    s_and_b32 s45, s2, 0x2
    s_lshl_b32 s45, s45, 13
    s_xor_b32 s30, s30, s45
    s_and_b32 s45, s2, 0x1
    s_lshl_b32 s45, s45, 17
    s_xor_b32 s30, s30, s45
    s_cmp_lt_u32 s34, 256
    s_cbranch_scc1 L_worker
    s_memtime s[52:53]
    v_and_b32 v1, 63, v0
    v_lshlrev_b32 v2, 4, v1
    v_mov_b32 v4, 0
    v_mov_b32 v5, 0
    v_mov_b32 v6, 0
    v_mov_b32 v7, 0
    v_mov_b32 v8, 0
    ds_write_b128 v2, v[4:7] offset:64
    ds_write_b128 v2, v[4:7] offset:1088
    s_mov_b64 exec, 1
    s_lshr_b32 s49, s2, 3
    s_mul_i32 s45, s49, 43
    s_lshr_b32 s45, s45, 7
    s_mul_i32 s45, s45, 3
    s_sub_u32 s49, s49, s45
    s_getreg_b32 s44, hwreg(HW_REG_XCC_ID)
    s_sub_u32 s45, s44, s2
    s_and_b32 s45, s45, 7
    s_lshl_b32 s45, s45, 1
    s_bfe_u32 s44, s44, 0x10002
    s_or_b32 s33, s45, s44
    s_or_b32 s33, s33, 0x100
    s_andn2_b32 s48, 0x4000, s30
    s_cmp_lt_u32 s2, 48
    s_waitcnt lgkmcnt(0)
    s_cbranch_scc0 L_noprobe
    s_cmp_eq_u32 s49, 0
    s_cselect_b32 s50, s12, s16
    s_cselect_b32 s51, s13, s17
    s_cmp_eq_u32 s49, 2
    s_cselect_b32 s50, s24, s50
    s_cselect_b32 s51, s25, s51
    s_mul_i32 s47, s52, 0x9e3779b1
    s_lshr_b32 s47, s47, 7
    s_and_b32 s47, s47, 0x1ffbf80
    s_or_b32 s47, s47, s48
    s_xor_b32 s48, s47, 0x2000
    s_memtime s[52:53]
    s_load_dword s58, s[50:51], s47
    s_load_dword s59, s[50:51], s48
    s_add_u32 s46, s47, s50
    s_lshr_b32 s45, s46, 8
    s_xor_b32 s45, s45, s46
    s_bfe_u32 s45, s45, 0x1000d
    s_xor_b32 s33, s33, s45
    s_lshl_b32 s44, s49, 2
    v_mov_b32 v9, s44
    v_mov_b32 v4, s33
    s_waitcnt lgkmcnt(1)
    s_memtime s[54:55]
    s_waitcnt lgkmcnt(0)
    s_memtime s[56:57]
    s_sub_u32 s45, s54, s52
    s_waitcnt lgkmcnt(0)
    s_sub_u32 s44, s56, s54
    s_cmp_gt_u32 s45, 300
    s_cselect_b32 s44, s44, 0
    s_cmp_gt_u32 s44, 200
    s_cbranch_scc0 L_noprobe
    global_atomic_cmpswap v9, v[4:5], s[28:29] sc1
L_noprobe:
    s_cmp_eq_u32 s2, 48
    s_cbranch_scc0 L_noinit
    s_mov_b64 exec, -1
    v_mul_u32_u24 v9, 0x1100, v1
    s_bfm_b64 exec, 32, 0
    v_add_u32 v10, 0, v9
    global_atomic_swap v3, v10, v5, s[4:5] sc0 sc1
    s_bfm_b64 exec, 32, 0
    v_add_u32 v11, 1048576, v9
    global_atomic_swap v3, v11, v5, s[4:5] sc0 sc1
    v_mov_b32 v4, 0x101
    s_waitcnt vmcnt(0)
    s_mov_b64 exec, 1
    global_atomic_cmpswap v8, v[4:5], s[28:29] offset:128 sc1
L_noinit:
    s_mov_b64 exec, -1
    v_add_u32 v21, 2, v1
    v_and_b32 v25, 0x2, v21
    v_lshlrev_b32 v25, 12, v25
    v_xor_b32 v20, s30, v25
    v_and_b32 v25, 0x7f, v21
    v_lshlrev_b32 v25, 20, v25
    v_xor_b32 v20, v20, v25
    v_add_u32 v22, s12, v20
    v_lshrrev_b32 v25, 8, v22
    v_xor_b32 v22, v22, v25
    v_add_u32 v23, s16, v20
    v_lshrrev_b32 v25, 8, v23
    v_xor_b32 v23, v23, v25
    v_add_u32 v24, s24, v20
    v_lshrrev_b32 v25, 8, v24
    v_xor_b32 v24, v24, v25
    v_lshlrev_b32 v2, 3, v1
    v_mov_b32 v21, 0x40000800
    s_mov_b32 s31, 32
    s_barrier
    s_load_dwordx4 s[60:63], s[28:29], 0
    s_waitcnt lgkmcnt(0)
L_check:
    s_and_b32 s44, s60, s61
    s_and_b32 s44, s44, s62
    s_bitcmp1_b32 s44, 8
    s_cbranch_scc1 L_have
    global_load_dwordx4 v[4:7], v8, s[28:29] sc1
    s_waitcnt vmcnt(0)
    v_readfirstlane_b32 s60, v4
    v_readfirstlane_b32 s61, v5
    v_readfirstlane_b32 s62, v6
    v_readfirstlane_b32 s63, v7
    s_sub_u32 s31, s31, 1
    s_cmp_lg_u32 s31, 0
    s_cbranch_scc1 L_check
    s_mov_b64 exec, 7
    v_lshlrev_b32 v3, 2, v1
    v_mov_b32 v4, 0x100
    v_mov_b32 v5, 0
    global_atomic_cmpswap v6, v3, v[4:5], s[28:29] sc0 sc1
    s_waitcnt vmcnt(0)
    v_readlane_b32 s60, v6, 0
    v_readlane_b32 s61, v6, 1
    v_readlane_b32 s62, v6, 2
    s_mov_b64 exec, -1
L_have:
    s_lshr_b32 s45, s60, 1
    s_add_u32 s45, s45, s2
    s_bfe_u32 s45, s45, 0x10002
    s_xor_b32 s52, s60, s45
    s_lshl_b32 s52, s52, 13
    s_xor_b32 s53, s61, s45
    s_lshl_b32 s53, s53, 13
    s_xor_b32 s54, s62, s45
    s_lshl_b32 s54, s54, 13
    v_xor_b32 v22, s52, v22
    v_xor_b32 v23, s53, v23
    v_xor_b32 v24, s54, v24
    v_bitop3_b32 v22, v22, v23, v24 bitop3:0xe8
    v_and_b32 v22, 0x2000, v22
    v_xad_u32 v20, v20, v22, 1
    s_bfm_b64 exec, 22, 0
    ds_write_b64 v2, v[20:21] offset:64
    s_branch L_helper2
L_worker:
    s_lshr_b32 s45, s2, 2
    s_xor_b32 s45, s44, s45
    s_and_b32 s45, s45, 1
    s_lshl_b32 s45, s45, 13
    s_xor_b32 s40, s30, s45
    s_xor_b32 s41, s40, 0x2000
    s_xor_b32 s36, s40, 0x2000000
    s_xor_b32 s37, s41, 0x2100000
    s_xor_b32 s38, s40, 0x2202000
    v_and_b32 v1, 0x20, v0
    v_lshlrev_b32 v1, 2, v1
    v_and_b32 v2, 0xd7, v0
    v_lshl_or_b32 v1, v2, 4, v1
    v_and_b32 v2, 0x8, v0
    v_lshl_or_b32 v1, v2, 6, v1
    v_and_b32 v2, 0x20, v0
    v_lshl_or_b32 v1, v2, 10, v1
    s_mov_b32 s14, 37748736
    s_mov_b32 s15, 0x20000
    s_mov_b32 s18, s14
    s_mov_b32 s19, s15
    s_mov_b32 s26, s14
    s_mov_b32 s27, s15
    v_mov_b32 v11, 0
    v_xor_b32 v49, s36, v1
    v_xor_b32 v50, s37, v1
    v_xor_b32 v51, s38, v1
    s_waitcnt lgkmcnt(0)
    global_load_ushort v10, v11, s[8:9]
    buffer_load_dwordx4 v[18:21], v49, s[16:19], 0 offen nt
    buffer_load_dwordx4 v[14:17], v49, s[12:15], 0 offen nt
    buffer_load_dword v40, v1, s[12:15], s14 offen
    buffer_load_dword v45, v1, s[12:15], s14 offen
    buffer_load_dwordx4 v[26:29], v50, s[16:19], 0 offen nt
    buffer_load_dwordx4 v[22:25], v50, s[12:15], 0 offen nt
    buffer_load_dword v41, v1, s[12:15], s14 offen
    buffer_load_dword v45, v1, s[12:15], s14 offen
    buffer_load_dwordx4 v[34:37], v51, s[16:19], 0 offen nt
    buffer_load_dwordx4 v[30:33], v51, s[12:15], 0 offen nt
    buffer_load_dword v42, v1, s[12:15], s14 offen
    s_mov_b32 s20, 0xffff0000
    s_mov_b32 s21, 0x40100000
    s_mov_b32 s6, 0x122000
    s_mov_b32 s7, s15
    s_mov_b32 s39, 0
    s_mov_b32 s35, 0x11
    v_mov_b32 v12, 32
    v_mov_b32 v39, 0x40000800
    s_xor_b32 s45, s41, 0x2302001
    v_mov_b32 v38, s45
    ds_write_b64 v12, v[38:39] offset:8
    s_xor_b32 s45, s40, 0x1
    v_mov_b32 v38, s45
    ds_write_b64 v12, v[38:39] offset:16
    s_xor_b32 s45, s41, 0x100001
    v_mov_b32 v38, s45
    ds_write_b64 v12, v[38:39] offset:24
    s_and_b32 s44, s44, 7
    s_lshl_b32 s44, s44, 2
    s_lshr_b32 s45, s34, 6
    s_add_u32 s44, s44, s45
    s_mul_i32 s44, s44, 0x1100
    v_mov_b32 v43, 0x40000000
    v_writelane_b32 v43, s44, 0
    s_waitcnt vmcnt(11)
    v_lshlrev_b32 v10, 16, v10
    v_mov_b32 v11, v10
L_loop:
    s_cmp_eq_u32 s36, s14
    s_cbranch_scc1 L_end
    v_add_u32_sdwa v12, v12, v39 dst_sel:DWORD dst_unused:UNUSED_PAD src0_sel:DWORD src1_sel:BYTE_1
    v_and_b32 v44, 0x80008, v39
    s_waitcnt vmcnt(8)
    v_mad_u32_u24 v13, v40, v44, v12
    v_lshlrev_b32 v2, 16, v18
    v_and_b32 v3, s20, v18
    v_pk_mul_f32 v[2:3], v[2:3], v[10:11]
    v_lshlrev_b32 v4, 16, v14
    v_and_b32 v5, s20, v14
    v_cvt_pk_bf16_f32 v18, v2, v3
    v_lshlrev_b32 v2, 16, v18
    v_and_b32 v3, s20, v18
    v_pk_add_f32 v[2:3], v[2:3], v[4:5]
    v_cvt_pk_bf16_f32 v14, v2, v3
    v_lshlrev_b32 v6, 16, v19
    v_and_b32 v7, s20, v19
    v_pk_mul_f32 v[6:7], v[6:7], v[10:11]
    v_lshlrev_b32 v8, 16, v15
    ds_read_b64 v[38:39], v13
    v_and_b32 v9, s20, v15
    v_cvt_pk_bf16_f32 v19, v6, v7
    v_lshlrev_b32 v6, 16, v19
    v_and_b32 v7, s20, v19
    v_pk_add_f32 v[6:7], v[6:7], v[8:9]
    v_cvt_pk_bf16_f32 v15, v6, v7
    v_lshlrev_b32 v2, 16, v20
    v_and_b32 v3, s20, v20
    v_pk_mul_f32 v[2:3], v[2:3], v[10:11]
    v_lshlrev_b32 v4, 16, v16
    v_and_b32 v5, s20, v16
    v_cvt_pk_bf16_f32 v20, v2, v3
    v_lshlrev_b32 v2, 16, v20
    v_and_b32 v3, s20, v20
    v_pk_add_f32 v[2:3], v[2:3], v[4:5]
    v_cvt_pk_bf16_f32 v16, v2, v3
    v_lshlrev_b32 v6, 16, v21
    v_and_b32 v7, s20, v21
    v_pk_mul_f32 v[6:7], v[6:7], v[10:11]
    v_lshlrev_b32 v8, 16, v17
    v_and_b32 v9, s20, v17
    v_cvt_pk_bf16_f32 v21, v6, v7
    v_lshlrev_b32 v6, 16, v21
    v_and_b32 v7, s20, v21
    v_pk_add_f32 v[6:7], v[6:7], v[8:9]
    v_cvt_pk_bf16_f32 v17, v6, v7
    buffer_store_dwordx4 v[14:17], v49, s[24:27], 0 offen sc0 sc1
L_got0:
    s_waitcnt lgkmcnt(0)
    v_readfirstlane_b32 s44, v38
    s_sub_u32 s36, s44, 1
    s_cbranch_scc1 L_retry0
    v_xor_b32 v49, s36, v1
    buffer_load_dwordx4 v[18:21], v49, s[16:19], 0 offen nt
    buffer_load_dwordx4 v[14:17], v49, s[12:15], 0 offen nt
    v_and_b32 v40, 0x10001, v39
    v_and_or_b32 v46, v39, s21, v43
    buffer_atomic_add v40, v46, s[4:7], 0 offen sc0 sc1
    s_cmp_eq_u32 s37, s14
    s_cbranch_scc1 L_end
    v_add_u32_sdwa v12, v12, v39 dst_sel:DWORD dst_unused:UNUSED_PAD src0_sel:DWORD src1_sel:BYTE_1
    v_and_b32 v44, 0x80008, v39
    s_waitcnt vmcnt(8)
    v_mad_u32_u24 v13, v41, v44, v12
    v_lshlrev_b32 v2, 16, v26
    v_and_b32 v3, s20, v26
    v_pk_mul_f32 v[2:3], v[2:3], v[10:11]
    v_lshlrev_b32 v4, 16, v22
    v_and_b32 v5, s20, v22
    v_cvt_pk_bf16_f32 v26, v2, v3
    v_lshlrev_b32 v2, 16, v26
    v_and_b32 v3, s20, v26
    v_pk_add_f32 v[2:3], v[2:3], v[4:5]
    v_cvt_pk_bf16_f32 v22, v2, v3
    v_lshlrev_b32 v6, 16, v27
    v_and_b32 v7, s20, v27
    v_pk_mul_f32 v[6:7], v[6:7], v[10:11]
    v_lshlrev_b32 v8, 16, v23
    ds_read_b64 v[38:39], v13
    v_and_b32 v9, s20, v23
    v_cvt_pk_bf16_f32 v27, v6, v7
    v_lshlrev_b32 v6, 16, v27
    v_and_b32 v7, s20, v27
    v_pk_add_f32 v[6:7], v[6:7], v[8:9]
    v_cvt_pk_bf16_f32 v23, v6, v7
    v_lshlrev_b32 v2, 16, v28
    v_and_b32 v3, s20, v28
    v_pk_mul_f32 v[2:3], v[2:3], v[10:11]
    v_lshlrev_b32 v4, 16, v24
    v_and_b32 v5, s20, v24
    v_cvt_pk_bf16_f32 v28, v2, v3
    v_lshlrev_b32 v2, 16, v28
    v_and_b32 v3, s20, v28
    v_pk_add_f32 v[2:3], v[2:3], v[4:5]
    v_cvt_pk_bf16_f32 v24, v2, v3
    v_lshlrev_b32 v6, 16, v29
    v_and_b32 v7, s20, v29
    v_pk_mul_f32 v[6:7], v[6:7], v[10:11]
    v_lshlrev_b32 v8, 16, v25
    v_and_b32 v9, s20, v25
    v_cvt_pk_bf16_f32 v29, v6, v7
    v_lshlrev_b32 v6, 16, v29
    v_and_b32 v7, s20, v29
    v_pk_add_f32 v[6:7], v[6:7], v[8:9]
    v_cvt_pk_bf16_f32 v25, v6, v7
    buffer_store_dwordx4 v[22:25], v50, s[24:27], 0 offen sc0 sc1
L_got1:
    s_waitcnt lgkmcnt(0)
    v_readfirstlane_b32 s44, v38
    s_sub_u32 s37, s44, 1
    s_cbranch_scc1 L_retry1
    v_xor_b32 v50, s37, v1
    buffer_load_dwordx4 v[26:29], v50, s[16:19], 0 offen nt
    buffer_load_dwordx4 v[22:25], v50, s[12:15], 0 offen nt
    v_and_b32 v41, 0x10001, v39
    v_and_or_b32 v46, v39, s21, v43
    buffer_atomic_add v41, v46, s[4:7], 0 offen sc0 sc1
    s_bitcmp1_b32 s35, 0
    s_cbranch_scc0 L_nobar
    s_barrier
L_nobar:
    s_cmp_eq_u32 s38, s14
    s_cbranch_scc1 L_end
    v_add_u32_sdwa v12, v12, v39 dst_sel:DWORD dst_unused:UNUSED_PAD src0_sel:DWORD src1_sel:BYTE_1
    v_and_b32 v44, 0x80008, v39
    s_waitcnt vmcnt(8)
    v_mad_u32_u24 v13, v42, v44, v12
    v_lshlrev_b32 v2, 16, v34
    v_and_b32 v3, s20, v34
    v_pk_mul_f32 v[2:3], v[2:3], v[10:11]
    v_lshlrev_b32 v4, 16, v30
    v_and_b32 v5, s20, v30
    v_cvt_pk_bf16_f32 v34, v2, v3
    v_lshlrev_b32 v2, 16, v34
    v_and_b32 v3, s20, v34
    v_pk_add_f32 v[2:3], v[2:3], v[4:5]
    v_cvt_pk_bf16_f32 v30, v2, v3
    v_lshlrev_b32 v6, 16, v35
    v_and_b32 v7, s20, v35
    v_pk_mul_f32 v[6:7], v[6:7], v[10:11]
    v_lshlrev_b32 v8, 16, v31
    ds_read_b64 v[38:39], v13
    v_and_b32 v9, s20, v31
    v_cvt_pk_bf16_f32 v35, v6, v7
    v_lshlrev_b32 v6, 16, v35
    v_and_b32 v7, s20, v35
    v_pk_add_f32 v[6:7], v[6:7], v[8:9]
    v_cvt_pk_bf16_f32 v31, v6, v7
    v_lshlrev_b32 v2, 16, v36
    v_and_b32 v3, s20, v36
    v_pk_mul_f32 v[2:3], v[2:3], v[10:11]
    v_lshlrev_b32 v4, 16, v32
    v_and_b32 v5, s20, v32
    v_cvt_pk_bf16_f32 v36, v2, v3
    v_lshlrev_b32 v2, 16, v36
    v_and_b32 v3, s20, v36
    v_pk_add_f32 v[2:3], v[2:3], v[4:5]
    v_cvt_pk_bf16_f32 v32, v2, v3
    v_lshlrev_b32 v6, 16, v37
    v_and_b32 v7, s20, v37
    v_pk_mul_f32 v[6:7], v[6:7], v[10:11]
    v_lshlrev_b32 v8, 16, v33
    v_and_b32 v9, s20, v33
    v_cvt_pk_bf16_f32 v37, v6, v7
    v_lshlrev_b32 v6, 16, v37
    v_and_b32 v7, s20, v37
    v_pk_add_f32 v[6:7], v[6:7], v[8:9]
    v_cvt_pk_bf16_f32 v33, v6, v7
    buffer_store_dwordx4 v[30:33], v51, s[24:27], 0 offen sc0 sc1
L_got2:
    s_waitcnt lgkmcnt(0)
    v_readfirstlane_b32 s44, v38
    s_sub_u32 s38, s44, 1
    s_cbranch_scc1 L_retry2
    v_xor_b32 v51, s38, v1
    buffer_load_dwordx4 v[34:37], v51, s[16:19], 0 offen nt
    buffer_load_dwordx4 v[30:33], v51, s[12:15], 0 offen nt
    v_and_b32 v42, 0x10001, v39
    v_and_or_b32 v46, v39, s21, v43
    buffer_atomic_add v42, v46, s[4:7], 0 offen sc0 sc1
    s_lshr_b32 s35, s35, 1
    s_branch L_loop
L_retry0:
    s_add_u32 s39, s39, 0x1000
    s_cbranch_scc1 L_end
    ds_read_b64 v[38:39], v13
    s_branch L_got0
L_retry1:
    s_add_u32 s39, s39, 0x1000
    s_cbranch_scc1 L_end
    ds_read_b64 v[38:39], v13
    s_branch L_got1
L_retry2:
    s_add_u32 s39, s39, 0x1000
    s_cbranch_scc1 L_end
    ds_read_b64 v[38:39], v13
    s_branch L_got2
L_helper2:
    s_mov_b64 exec, 1
    s_barrier
    s_load_dword s63, s[28:29], 128
    s_waitcnt lgkmcnt(0)
    s_mov_b32 s31, 8
L_mpoll:
    s_bitcmp1_b32 s63, 8
    s_cbranch_scc1 L_mode
    global_load_dword v6, v8, s[28:29] offset:128 sc1
    s_waitcnt vmcnt(0)
    v_readfirstlane_b32 s63, v6
    s_sub_u32 s31, s31, 1
    s_cmp_lg_u32 s31, 0
    s_cbranch_scc1 L_mpoll
    v_mov_b32 v4, 0x100
    v_mov_b32 v5, 0
    global_atomic_cmpswap v6, v8, v[4:5], s[28:29] offset:128 sc0 sc1
    s_waitcnt vmcnt(0)
    v_readfirstlane_b32 s63, v6
L_mode:
    s_mov_b64 exec, -1
    s_lshr_b32 s44, s2, 3
    s_and_b32 s55, s2, 0x20
    s_lshl_b32 s55, s55, 7
    s_and_b32 s46, s2, 0x18
    s_lshl_b32 s46, s46, 12
    s_xor_b32 s55, s55, s46
    s_lshr_b32 s44, s44, 3
    s_lshl_b32 s44, s44, 2
    s_and_b32 s46, s2, 3
    s_or_b32 s44, s44, s46
    s_lshl_b32 s40, s45, 20
    s_or_b32 s40, s40, 1
    s_and_b32 s41, s40, 0x10001
    s_lshl_b32 s41, s41, 3
    s_or_b32 s41, s41, s40
    s_or_b32 s40, s40, 0x800
    s_or_b32 s42, s41, 0x800
    s_movk_i32 s43, 0x2000
    s_bitcmp1_b32 s63, 0
    s_cselect_b32 s56, 0, 4
    s_cselect_b32 s44, 0, s44
    s_cselect_b32 s57, 80, 80
    s_cselect_b32 s40, s40, 0x40000800
    s_cselect_b32 s41, s41, 0x40000800
    s_cselect_b32 s42, s42, 0x40000800
    s_or_b32 s58, s41, 0x40000000
    v_mov_b32 v11, 37748737
    v_mov_b32 v12, s58
    v_mov_b32 v13, s41
    v_add_u32 v10, 0, v1
    v_lshlrev_b32 v10, s56, v10
    v_add_u32 v10, s44, v10
    v_cmp_le_u32 vcc, s57, v10
    v_add_u32 v27, 432, v10
    v_and_b32 v22, 0x20, v27
    v_lshlrev_b32 v22, 8, v22
    v_xor_b32 v28, s55, v22
    v_and_b32 v22, 0x2, v27
    v_lshlrev_b32 v22, 13, v22
    v_xor_b32 v28, v28, v22
    v_and_b32 v22, 0x3fc, v27
    v_lshlrev_b32 v22, 16, v22
    v_xor_b32 v28, v28, v22
    v_and_b32 v22, 0x1, v27
    v_lshlrev_b32 v22, 17, v22
    v_xor_b32 v28, v28, v22
    v_add_u32 v22, s12, v28
    v_lshrrev_b32 v26, 8, v22
    v_bitop3_b32 v22, v22, v26, s52 bitop3:0x96
    v_add_u32 v23, s16, v28
    v_lshrrev_b32 v26, 8, v23
    v_bitop3_b32 v23, v23, v26, s53 bitop3:0x96
    v_add_u32 v24, s24, v28
    v_lshrrev_b32 v26, 8, v24
    v_bitop3_b32 v24, v24, v26, s54 bitop3:0x96
    v_bitop3_b32 v22, v22, v23, v24 bitop3:0xe8
    v_and_b32 v22, 0x2000, v22
    v_xad_u32 v28, v28, v22, 1
    v_cndmask_b32 v28, v28, v11, vcc
    v_cndmask_b32 v29, v13, v12, vcc
    ds_write_b64 v2, v[28:29] offset:264
    v_add_u32 v10, 64, v1
    v_lshlrev_b32 v10, s56, v10
    v_add_u32 v10, s44, v10
    v_cmp_le_u32 vcc, s57, v10
    v_add_u32 v27, 432, v10
    v_and_b32 v22, 0x20, v27
    v_lshlrev_b32 v22, 8, v22
    v_xor_b32 v28, s55, v22
    v_and_b32 v22, 0x2, v27
    v_lshlrev_b32 v22, 13, v22
    v_xor_b32 v28, v28, v22
    v_and_b32 v22, 0x3fc, v27
    v_lshlrev_b32 v22, 16, v22
    v_xor_b32 v28, v28, v22
    v_and_b32 v22, 0x1, v27
    v_lshlrev_b32 v22, 17, v22
    v_xor_b32 v28, v28, v22
    v_add_u32 v22, s12, v28
    v_lshrrev_b32 v26, 8, v22
    v_bitop3_b32 v22, v22, v26, s52 bitop3:0x96
    v_add_u32 v23, s16, v28
    v_lshrrev_b32 v26, 8, v23
    v_bitop3_b32 v23, v23, v26, s53 bitop3:0x96
    v_add_u32 v24, s24, v28
    v_lshrrev_b32 v26, 8, v24
    v_bitop3_b32 v24, v24, v26, s54 bitop3:0x96
    v_bitop3_b32 v22, v22, v23, v24 bitop3:0xe8
    v_and_b32 v22, 0x2000, v22
    v_xad_u32 v28, v28, v22, 1
    v_cndmask_b32 v28, v28, v11, vcc
    v_cndmask_b32 v29, v13, v12, vcc
    ds_write_b64 v2, v[28:29] offset:776
    v_add_u32 v10, 128, v1
    v_lshlrev_b32 v10, s56, v10
    v_add_u32 v10, s44, v10
    v_cmp_le_u32 vcc, s57, v10
    s_nop 1
    v_cndmask_b32 v28, v28, v11, vcc
    v_cndmask_b32 v29, v13, v12, vcc
    ds_write_b64 v2, v[28:29] offset:1288
    v_mov_b32 v21, s40
    v_writelane_b32 v21, s42, 24
    s_bfm_b64 exec, 3, 22
    ds_write_b64 v2, v[20:21] offset:64
    s_endpgm
L_end:
    s_endpgm
.section .rodata,"a"
.p2align 6
.amdhsa_kernel standalone__rezero__sampling_kernel
  .amdhsa_next_free_vgpr 52
  .amdhsa_next_free_sgpr 64
  .amdhsa_accum_offset 52
  .amdhsa_group_segment_fixed_size 0
  .amdhsa_kernarg_size 48
  .amdhsa_user_sgpr_count 2
  .amdhsa_user_sgpr_kernarg_segment_ptr 1
  .amdhsa_system_sgpr_workgroup_id_x 1
  .amdhsa_float_denorm_mode_32 3
  .amdhsa_float_denorm_mode_16_64 3
.end_amdhsa_kernel
```
